```python
import torch

def _softmax(x, axis=-1):
    return torch.softmax(x, dim=axis)
def _gelu(x):
    return torch.nn.functional.gelu(x, approximate="tanh")
def _silu(x):
    return torch.nn.functional.silu(x)
def _sigmoid(x):
    return torch.sigmoid(x)
def _layernorm(x, axis=-1, eps=1e-5):
    m = x.mean(dim=axis, keepdim=True)
    v = x.var(dim=axis, keepdim=True, unbiased=False)
    return (x - m) / torch.sqrt(v + eps)
def _scatter_add(tgt, idx, src, axis=0):
    return tgt.clone().index_add_(axis, idx, src)
def _segment_sum(src, seg, n):
    out = torch.zeros((n,) + src.shape[1:], dtype=src.dtype)
    return out.index_add_(0, seg, src)
def _pad(x, pw):
    flat = tuple(v for pair in reversed(pw) for v in pair)
    return torch.nn.functional.pad(x, flat)

kernel_name = 'standalone__glu_gated_glu__sampling'

def setup_inputs():

    _w = (lambda a: (lambda t: t.to(torch.bfloat16) if t.is_floating_point() else t)(torch.as_tensor(a)))
    B, S, D, F = 8, 8, 1024, 3584
    return {
        "x": _w((lambda *s: torch.randn(*s, dtype=torch.bfloat16) * 0.1)(B, S, D)),
        "w_gate": _w((lambda *s: torch.randn(*s, dtype=torch.bfloat16) * 0.1)(D, F)),
        "w_up": _w((lambda *s: torch.randn(*s, dtype=torch.bfloat16) * 0.05)(D, F)),
        "w_down": _w((lambda *s: torch.randn(*s, dtype=torch.bfloat16) * 0.05)(F, D)),
    }

def reference(x, w_gate, w_up, w_down):
    g = torch.einsum("bsd,df->bsf", x, w_gate)
    u = torch.einsum("bsd,df->bsf", x, w_up)
    h = _sigmoid(g) * u
    return torch.einsum("bsf,fd->bsd", h, w_down)
```

```asm
; @launch grid=(256,1,1) block=(512,1,1) lds=122880
.amdgcn_target "amdgcn-amd-amdhsa--gfx950"
.text
.globl standalone__glu_gated_glu__sampling_kernel
.p2align 8
.type standalone__glu_gated_glu__sampling_kernel,@function
standalone__glu_gated_glu__sampling_kernel:
  s_cmp_ge_u32 s2, 256
  s_cbranch_scc1 L_end
  s_load_dwordx2 s[20:21], s[0:1], 0
  s_load_dwordx2 s[24:25], s[0:1], 8
  s_load_dwordx2 s[4:5], s[0:1], 16
  s_load_dwordx2 s[28:29], s[0:1], 24
  s_load_dwordx2 s[36:37], s[0:1], 32
  s_load_dwordx2 s[40:41], s[0:1], 40
  s_load_dwordx2 s[32:33], s[0:1], 48
  v_lshrrev_b32 v14, 6, v0
  v_and_b32 v1, 63, v0
  s_and_b32 s8, s2, 7
  v_readfirstlane_b32 s11, v14
  s_bfe_u32 s9, s2, 0x10003
  s_lshr_b32 s10, s2, 4
  s_add_u32 s10, s10, 14
  s_and_b32 s10, s10, 15
  s_mov_b32 s6, 7340032
  s_mov_b32 s7, 0x20000
  s_mov_b32 s22, 131072
  s_mov_b32 s23, 0x20000
  s_mov_b32 s26, 7340032
  s_mov_b32 s27, 0x20000
  s_mov_b32 s30, 7340032
  s_mov_b32 s31, 0x20000
  s_mov_b32 s34, 3080192
  s_mov_b32 s35, 0x20000
  s_mov_b32 s38, 131072
  s_mov_b32 s39, 0x20000
  s_mov_b32 s58, 0
  s_mov_b32 s93, 1
  s_mov_b32 s90, 0
  s_mov_b32 s88, 2
  s_mov_b32 s42, 256
  s_mov_b32 s43, 0x20000
  s_and_b32 s12, s11, 1
  s_lshr_b32 s59, s11, 1
  s_cmp_ge_u32 s10, 14
  s_cbranch_scc1 L_extra
  s_cmp_eq_u32 s9, 0
  s_cbranch_scc0 L_helper
  s_cmp_lt_u32 s11, 4
  s_cbranch_scc1 L_comp
  s_sub_u32 s53, s11, 4
  s_mul_i32 s17, s8, 896
  s_lshl_b32 s19, s10, 6
  s_add_u32 s17, s17, s19
  v_lshrrev_b32 v14, 2, v1
  s_lshl_b32 s19, s53, 4
  v_add_u32 v14, s19, v14
  v_mul_u32_u24 v14, 7168, v14
  v_lshrrev_b32 v15, 5, v1
  v_lshlrev_b32 v15, 1, v15
  v_and_b32 v16, 3, v1
  v_xor_b32 v15, v15, v16
  v_lshl_add_u32 v2, v15, 4, v14
  v_lshrrev_b32 v14, 3, v1
  v_add_u32 v14, s19, v14
  v_and_b32 v15, 7, v1
  v_lshrrev_b32 v16, 4, v1
  v_xor_b32 v16, v15, v16
  v_lshlrev_b32 v16, 4, v16
  v_lshl_add_u32 v3, v14, 11, v16
  v_xor_b32 v16, 64, v16
  v_add_u32 v14, 8, v14
  v_lshl_add_u32 v4, v14, 11, v16
  s_mov_b32 s18, 0
  s_lshl_b32 s16, s53, 12
  s_add_u32 s50, s16, 65536
  s_mov_b32 s14, 0
  s_waitcnt lgkmcnt(0)
L_lpro:
  s_mov_b32 m0, s16
  s_add_u32 s16, s16, 16384
  buffer_load_dwordx4 v2, s[24:27], s17 offen lds
  s_add_u32 m0, m0, 1024
  s_cmp_ge_u32 s16, s50
  buffer_load_dwordx4 v2, s[4:7], s17 offen lds
  s_cselect_b32 s19, 65536, 0
  s_add_u32 m0, m0, 1024
  s_sub_u32 s16, s16, s19
  buffer_load_dwordx4 v3, s[20:23], s18 offen lds
  s_add_u32 m0, m0, 1024
  s_add_u32 s17, s17, 458752
  buffer_load_dwordx4 v4, s[20:23], s18 offen lds
  s_add_u32 s18, s18, 128
  s_add_u32 s14, s14, 1
  s_cmp_lt_u32 s14, 2
  s_cbranch_scc1 L_lpro
  v_lshrrev_b32 v14, 3, v1
  v_and_b32 v15, 7, v1
  v_bfe_u32 v16, v1, 4, 2
  v_lshlrev_b32 v16, 1, v16
  v_xor_b32 v16, v15, v16
  v_lshlrev_b32 v16, 4, v16
  v_lshl_add_u32 v60, v14, 11, v16
  s_mul_i32 s55, s8, 917504
  s_lshl_b32 s19, s10, 7
  s_add_u32 s55, s55, s19
  s_movk_i32 s56, 1024
  s_movk_i32 s57, 16384
  s_lshl_b32 s19, s12, 10
  v_lshlrev_b32 v72, 4, v1
  v_add_u32 v61, s19, v72
  s_sub_i32 s19, s59, 1
  s_max_i32 s19, s19, 0
  s_lshl_b32 s3, s59, 2
  s_sub_u32 s3, s3, s19
  v_lshrrev_b32 v14, 2, v1
  v_lshlrev_b32 v14, 7, v14
  v_bfe_u32 v15, v1, 3, 2
  v_xor_b32 v15, s59, v15
  v_lshl_add_u32 v14, v15, 5, v14
  v_and_b32 v15, 3, v1
  v_lshl_add_u32 v14, v15, 3, v14
  s_lshl_b32 s19, s3, 12
  s_add_u32 s19, s19, 65536
  v_add_u32 v67, s19, v14
  v_xor_b32 v68, 32, v67
  v_xor_b32 v69, 64, v67
  v_xor_b32 v70, 96, v67
  v_lshrrev_b32 v14, 4, v1
  s_lshl_b32 s19, s12, 2
  v_add_u32 v14, s19, v14
  v_lshlrev_b32 v14, 13, v14
  v_and_b32 v15, 15, v1
  v_lshl_add_u32 v14, v15, 4, v14
  s_lshl_b32 s19, s59, 8
  v_add_u32 v62, s19, v14
  s_mul_i32 s19, s11, 3072
  s_add_u32 s19, s19, 0
  v_add_u32 v63, s19, v72
  s_xor_b32 s19, s11, 2
  s_mul_i32 s19, s19, 3072
  s_add_u32 s19, s19, 0
  v_add_u32 v64, s19, v72
  s_xor_b32 s19, s11, 4
  s_mul_i32 s19, s19, 3072
  s_add_u32 s19, s19, 1024
  v_add_u32 v65, s19, v72
  s_xor_b32 s19, s11, 6
  s_mul_i32 s19, s19, 3072
  s_add_u32 s19, s19, 2048
  v_add_u32 v66, s19, v72
  s_lshl_b32 s19, s8, 1
  s_add_u32 s19, s19, s9
  s_mul_i32 s45, s19, 28672
  s_lshl_b32 s19, s9, 4
  s_add_u32 s19, s19, s10
  s_lshl_b32 s19, s19, 16
  s_add_u32 s46, s19, 524288
  s_mov_b32 s44, 0xffff0000
  s_mov_b32 s89, 0xffff
  s_mov_b32 m0, s16
  s_add_u32 s16, s16, 16384
  buffer_load_dwordx4 v2, s[24:27], s17 offen lds
  s_add_u32 m0, m0, 1024
  s_cmp_ge_u32 s16, s50
  buffer_load_dwordx4 v2, s[4:7], s17 offen lds
  s_cselect_b32 s19, 65536, 0
  s_add_u32 m0, m0, 1024
  s_sub_u32 s16, s16, s19
  buffer_load_dwordx4 v3, s[20:23], s18 offen lds
  s_add_u32 m0, m0, 1024
  s_add_u32 s17, s17, 458752
  buffer_load_dwordx4 v4, s[20:23], s18 offen lds
  s_add_u32 s18, s18, 128
  s_waitcnt vmcnt(8)
  s_barrier
  s_mov_b32 m0, s16
  s_add_u32 s16, s16, 16384
  buffer_load_dwordx4 v2, s[24:27], s17 offen lds
  s_add_u32 m0, m0, 1024
  s_cmp_ge_u32 s16, s50
  buffer_load_dwordx4 v2, s[4:7], s17 offen lds
  s_cselect_b32 s19, 65536, 0
  s_add_u32 m0, m0, 1024
  s_sub_u32 s16, s16, s19
  buffer_load_dwordx4 v3, s[20:23], s18 offen lds
  s_add_u32 m0, m0, 1024
  s_add_u32 s17, s17, 458752
  buffer_load_dwordx4 v4, s[20:23], s18 offen lds
  s_add_u32 s18, s18, 128
  s_mov_b32 s14, 1
L_lmain:
  s_waitcnt vmcnt(8)
  s_barrier
  s_mov_b32 m0, s16
  s_add_u32 s16, s16, 16384
  buffer_load_dwordx4 v2, s[24:27], s17 offen lds
  s_add_u32 m0, m0, 1024
  s_cmp_ge_u32 s16, s50
  buffer_load_dwordx4 v2, s[4:7], s17 offen lds
  s_cselect_b32 s19, 65536, 0
  s_add_u32 m0, m0, 1024
  s_sub_u32 s16, s16, s19
  buffer_load_dwordx4 v3, s[20:23], s18 offen lds
  s_add_u32 m0, m0, 1024
  s_add_u32 s17, s17, 458752
  buffer_load_dwordx4 v4, s[20:23], s18 offen lds
  s_add_u32 s18, s18, 128
  s_add_u32 s14, s14, 1
  s_cmp_lt_u32 s14, 13
  s_cbranch_scc1 L_lmain
  s_waitcnt vmcnt(8)
  s_barrier
  s_waitcnt vmcnt(4)
  s_barrier
  s_waitcnt vmcnt(0)
  s_barrier
  s_mul_i32 s49, s53, 14
  s_lshl_b32 s19, s49, 10
  s_add_u32 m0, s19, 65536
  s_lshl_b32 s19, s49, 14
  s_add_u32 s48, s55, s19
  buffer_load_dwordx4 v60, s[28:31], s48 offen lds
  s_add_u32 m0, m0, s56
  s_add_u32 s48, s48, s57
  buffer_load_dwordx4 v60, s[28:31], s48 offen lds
  s_add_u32 m0, m0, s56
  s_add_u32 s48, s48, s57
  buffer_load_dwordx4 v60, s[28:31], s48 offen lds
  s_add_u32 m0, m0, s56
  s_add_u32 s48, s48, s57
  buffer_load_dwordx4 v60, s[28:31], s48 offen lds
  s_add_u32 m0, m0, s56
  s_add_u32 s48, s48, s57
  buffer_load_dwordx4 v60, s[28:31], s48 offen lds
  s_add_u32 m0, m0, s56
  s_add_u32 s48, s48, s57
  buffer_load_dwordx4 v60, s[28:31], s48 offen lds
  s_add_u32 m0, m0, s56
  s_add_u32 s48, s48, s57
  buffer_load_dwordx4 v60, s[28:31], s48 offen lds
  s_add_u32 m0, m0, s56
  s_add_u32 s48, s48, s57
  buffer_load_dwordx4 v60, s[28:31], s48 offen lds
  s_add_u32 m0, m0, s56
  s_add_u32 s48, s48, s57
  buffer_load_dwordx4 v60, s[28:31], s48 offen lds
  s_add_u32 m0, m0, s56
  s_add_u32 s48, s48, s57
  buffer_load_dwordx4 v60, s[28:31], s48 offen lds
  s_add_u32 m0, m0, s56
  s_add_u32 s48, s48, s57
  buffer_load_dwordx4 v60, s[28:31], s48 offen lds
  s_add_u32 m0, m0, s56
  s_add_u32 s48, s48, s57
  buffer_load_dwordx4 v60, s[28:31], s48 offen lds
  s_add_u32 m0, m0, s56
  s_add_u32 s48, s48, s57
  buffer_load_dwordx4 v60, s[28:31], s48 offen lds
  s_add_u32 m0, m0, s56
  s_add_u32 s48, s48, s57
  buffer_load_dwordx4 v60, s[28:31], s48 offen lds
  s_branch L_S
L_comp:
  v_lshrrev_b32 v14, 5, v1
  v_lshlrev_b32 v14, 12, v14
  v_bfe_u32 v15, v1, 4, 1
  v_lshl_add_u32 v14, v15, 9, v14
  v_lshl_add_u32 v14, v15, 5, v14
  v_bfe_u32 v15, v1, 2, 2
  v_lshl_add_u32 v14, v15, 6, v14
  v_and_b32 v15, 3, v1
  v_lshl_add_u32 v5, v15, 3, v14
  v_xor_b32 v6, 32, v5
  v_and_b32 v14, 15, v1
  v_lshlrev_b32 v14, 7, v14
  v_lshrrev_b32 v15, 4, v1
  v_bfe_u32 v16, v1, 1, 3
  v_xor_b32 v15, v15, v16
  v_lshl_add_u32 v14, v15, 4, v14
  s_lshl_b32 s19, s11, 12
  s_add_u32 s19, s19, 2048
  v_add_u32 v7, s19, v14
  v_xor_b32 v8, 64, v7
  v_mov_b32 v152, 0
  v_mov_b32 v153, 0
  v_mov_b32 v154, 0
  v_mov_b32 v155, 0
  v_mov_b32 v156, 0
  v_mov_b32 v157, 0
  v_mov_b32 v158, 0
  v_mov_b32 v159, 0
  v_mov_b32 v160, 0
  v_mov_b32 v161, 0
  v_mov_b32 v162, 0
  v_mov_b32 v163, 0
  v_mov_b32 v164, 0
  v_mov_b32 v165, 0
  v_mov_b32 v166, 0
  v_mov_b32 v167, 0
  v_lshrrev_b32 v14, 3, v1
  v_and_b32 v15, 7, v1
  v_bfe_u32 v16, v1, 4, 2
  v_lshlrev_b32 v16, 1, v16
  v_xor_b32 v16, v15, v16
  v_lshlrev_b32 v16, 4, v16
  v_lshl_add_u32 v60, v14, 11, v16
  s_mul_i32 s55, s8, 917504
  s_lshl_b32 s19, s10, 7
  s_add_u32 s55, s55, s19
  s_movk_i32 s56, 1024
  s_movk_i32 s57, 16384
  s_lshl_b32 s19, s12, 10
  v_lshlrev_b32 v72, 4, v1
  v_add_u32 v61, s19, v72
  s_sub_i32 s19, s59, 1
  s_max_i32 s19, s19, 0
  s_lshl_b32 s3, s59, 2
  s_sub_u32 s3, s3, s19
  v_lshrrev_b32 v14, 2, v1
  v_lshlrev_b32 v14, 7, v14
  v_bfe_u32 v15, v1, 3, 2
  v_xor_b32 v15, s59, v15
  v_lshl_add_u32 v14, v15, 5, v14
  v_and_b32 v15, 3, v1
  v_lshl_add_u32 v14, v15, 3, v14
  s_lshl_b32 s19, s3, 12
  s_add_u32 s19, s19, 65536
  v_add_u32 v67, s19, v14
  v_xor_b32 v68, 32, v67
  v_xor_b32 v69, 64, v67
  v_xor_b32 v70, 96, v67
  v_lshrrev_b32 v14, 4, v1
  s_lshl_b32 s19, s12, 2
  v_add_u32 v14, s19, v14
  v_lshlrev_b32 v14, 13, v14
  v_and_b32 v15, 15, v1
  v_lshl_add_u32 v14, v15, 4, v14
  s_lshl_b32 s19, s59, 8
  v_add_u32 v62, s19, v14
  s_mul_i32 s19, s11, 3072
  s_add_u32 s19, s19, 0
  v_add_u32 v63, s19, v72
  s_xor_b32 s19, s11, 2
  s_mul_i32 s19, s19, 3072
  s_add_u32 s19, s19, 0
  v_add_u32 v64, s19, v72
  s_xor_b32 s19, s11, 4
  s_mul_i32 s19, s19, 3072
  s_add_u32 s19, s19, 1024
  v_add_u32 v65, s19, v72
  s_xor_b32 s19, s11, 6
  s_mul_i32 s19, s19, 3072
  s_add_u32 s19, s19, 2048
  v_add_u32 v66, s19, v72
  s_lshl_b32 s19, s8, 1
  s_add_u32 s19, s19, s9
  s_mul_i32 s45, s19, 28672
  s_lshl_b32 s19, s9, 4
  s_add_u32 s19, s19, s10
  s_lshl_b32 s19, s19, 16
  s_add_u32 s46, s19, 524288
  s_mov_b32 s44, 0xffff0000
  s_mov_b32 s89, 0xffff
  s_lshl_b32 s19, s8, 1
  s_add_u32 s19, s19, s59
  s_mul_i32 s54, s19, 28672
  s_lshl_b32 s19, s10, 1
  s_add_u32 s19, s19, s12
  s_lshl_b32 s19, s19, 10
  s_add_u32 s54, s54, s19
  s_mul_i32 s87, s8, 14
  s_add_u32 s87, s87, s10
  s_lshl_b32 s87, s87, 2
  s_add_u32 s87, s87, s11
  s_lshl_b32 s87, s87, 7
  s_add_u32 s87, s87, 458752
  s_mov_b32 s15, 0
  s_mov_b32 s14, 0
  s_cmp_eq_u32 s11, 0
  s_cselect_b32 s94, 10, 99
  s_cselect_b32 s95, 14, 99
  s_waitcnt lgkmcnt(0)
  v_add_u32 v9, s15, v5
  v_add_u32 v10, s15, v6
  v_add_u32 v11, s15, v7
  v_add_u32 v12, s15, v8
  s_add_u32 s15, s15, 16384
  s_cmp_ge_u32 s15, 65536
  s_cselect_b32 s19, 65536, 0
  s_sub_u32 s15, s15, s19
  s_barrier
  ds_read_b128 v[20:23], v11
  ds_read_b64_tr_b16 v[28:29], v9 offset:0
  ds_read_b64_tr_b16 v[30:31], v9 offset:256
  ds_read_b64_tr_b16 v[32:33], v10 offset:0
  ds_read_b64_tr_b16 v[34:35], v10 offset:256
  ds_read_b64_tr_b16 v[36:37], v9 offset:1024
  ds_read_b64_tr_b16 v[38:39], v9 offset:1280
  ds_read_b64_tr_b16 v[40:41], v10 offset:1024
  ds_read_b64_tr_b16 v[42:43], v10 offset:1280
  ds_read_b128 v[24:27], v12
  ds_read_b64_tr_b16 v[44:45], v9 offset:8192
  ds_read_b64_tr_b16 v[46:47], v9 offset:8448
  ds_read_b64_tr_b16 v[48:49], v10 offset:8192
  ds_read_b64_tr_b16 v[50:51], v10 offset:8448
  ds_read_b64_tr_b16 v[52:53], v9 offset:9216
  ds_read_b64_tr_b16 v[54:55], v9 offset:9472
  ds_read_b64_tr_b16 v[56:57], v10 offset:9216
  ds_read_b64_tr_b16 v[58:59], v10 offset:9472
L_main:
  v_add_u32 v9, s15, v5
  v_add_u32 v10, s15, v6
  v_add_u32 v11, s15, v7
  v_add_u32 v12, s15, v8
  s_add_u32 s15, s15, 16384
  s_cmp_ge_u32 s15, 65536
  s_cselect_b32 s19, 65536, 0
  s_sub_u32 s15, s15, s19
  s_waitcnt lgkmcnt(0)
  s_barrier
  v_mfma_f32_16x16x32_bf16 v[152:155], v[28:31], v[20:23], v[152:155]
  ds_read_b128 v[104:107], v11
  ds_read_b64_tr_b16 v[112:113], v9 offset:0
  ds_read_b64_tr_b16 v[114:115], v9 offset:256
  v_mfma_f32_16x16x32_bf16 v[156:159], v[32:35], v[20:23], v[156:159]
  ds_read_b64_tr_b16 v[116:117], v10 offset:0
  ds_read_b64_tr_b16 v[118:119], v10 offset:256
  ds_read_b64_tr_b16 v[120:121], v9 offset:1024
  v_mfma_f32_16x16x32_bf16 v[160:163], v[36:39], v[20:23], v[160:163]
  ds_read_b64_tr_b16 v[122:123], v9 offset:1280
  ds_read_b64_tr_b16 v[124:125], v10 offset:1024
  v_mfma_f32_16x16x32_bf16 v[164:167], v[40:43], v[20:23], v[164:167]
  ds_read_b64_tr_b16 v[126:127], v10 offset:1280
  ds_read_b128 v[108:111], v12
  v_mfma_f32_16x16x32_bf16 v[152:155], v[44:47], v[24:27], v[152:155]
  ds_read_b64_tr_b16 v[128:129], v9 offset:8192
  ds_read_b64_tr_b16 v[130:131], v9 offset:8448
  v_mfma_f32_16x16x32_bf16 v[156:159], v[48:51], v[24:27], v[156:159]
  ds_read_b64_tr_b16 v[132:133], v10 offset:8192
  ds_read_b64_tr_b16 v[134:135], v10 offset:8448
  v_mfma_f32_16x16x32_bf16 v[160:163], v[52:55], v[24:27], v[160:163]
  ds_read_b64_tr_b16 v[136:137], v9 offset:9216
  ds_read_b64_tr_b16 v[138:139], v9 offset:9472
  v_mfma_f32_16x16x32_bf16 v[164:167], v[56:59], v[24:27], v[164:167]
  ds_read_b64_tr_b16 v[140:141], v10 offset:9216
  ds_read_b64_tr_b16 v[142:143], v10 offset:9472
  s_cmp_eq_u32 s14, s94
  s_cbranch_scc0 L_nochk
  buffer_load_dword v13, off, s[40:43], 0 sc1
L_nochk:
  s_cmp_eq_u32 s14, 14
  s_cbranch_scc1 L_last
  s_add_u32 s14, s14, 2
  s_cmp_eq_u32 s14, s95
  s_cbranch_scc0 L_even
  s_waitcnt vmcnt(0)
L_chk:
  v_cmp_gt_u32 vcc, 32, v13
  s_nop 4
  s_cbranch_vccz L_even
  s_add_u32 s58, s58, 1
  s_cmp_gt_u32 s58, 0x8000
  s_cbranch_scc1 L_even
  s_sleep 8
  buffer_load_dword v13, off, s[40:43], 0 sc1
  s_waitcnt vmcnt(0)
  s_branch L_chk
L_even:
  v_add_u32 v9, s15, v5
  v_add_u32 v10, s15, v6
  v_add_u32 v11, s15, v7
  v_add_u32 v12, s15, v8
  s_add_u32 s15, s15, 16384
  s_cmp_ge_u32 s15, 65536
  s_cselect_b32 s19, 65536, 0
  s_sub_u32 s15, s15, s19
  s_waitcnt lgkmcnt(0)
  s_barrier
  v_mfma_f32_16x16x32_bf16 v[152:155], v[112:115], v[104:107], v[152:155]
  ds_read_b128 v[20:23], v11
  ds_read_b64_tr_b16 v[28:29], v9 offset:0
  ds_read_b64_tr_b16 v[30:31], v9 offset:256
  v_mfma_f32_16x16x32_bf16 v[156:159], v[116:119], v[104:107], v[156:159]
  ds_read_b64_tr_b16 v[32:33], v10 offset:0
  ds_read_b64_tr_b16 v[34:35], v10 offset:256
  ds_read_b64_tr_b16 v[36:37], v9 offset:1024
  v_mfma_f32_16x16x32_bf16 v[160:163], v[120:123], v[104:107], v[160:163]
  ds_read_b64_tr_b16 v[38:39], v9 offset:1280
  ds_read_b64_tr_b16 v[40:41], v10 offset:1024
  v_mfma_f32_16x16x32_bf16 v[164:167], v[124:127], v[104:107], v[164:167]
  ds_read_b64_tr_b16 v[42:43], v10 offset:1280
  ds_read_b128 v[24:27], v12
  v_mfma_f32_16x16x32_bf16 v[152:155], v[128:131], v[108:111], v[152:155]
  ds_read_b64_tr_b16 v[44:45], v9 offset:8192
  ds_read_b64_tr_b16 v[46:47], v9 offset:8448
  v_mfma_f32_16x16x32_bf16 v[156:159], v[132:135], v[108:111], v[156:159]
  ds_read_b64_tr_b16 v[48:49], v10 offset:8192
  ds_read_b64_tr_b16 v[50:51], v10 offset:8448
  v_mfma_f32_16x16x32_bf16 v[160:163], v[136:139], v[108:111], v[160:163]
  ds_read_b64_tr_b16 v[52:53], v9 offset:9216
  ds_read_b64_tr_b16 v[54:55], v9 offset:9472
  v_mfma_f32_16x16x32_bf16 v[164:167], v[140:143], v[108:111], v[164:167]
  ds_read_b64_tr_b16 v[56:57], v10 offset:9216
  ds_read_b64_tr_b16 v[58:59], v10 offset:9472
  s_branch L_main
L_last:
  s_waitcnt lgkmcnt(0)
  v_mfma_f32_16x16x32_bf16 v[152:155], v[112:115], v[104:107], v[152:155]
  v_mfma_f32_16x16x32_bf16 v[156:159], v[116:119], v[104:107], v[156:159]
  v_mfma_f32_16x16x32_bf16 v[152:155], v[128:131], v[108:111], v[152:155]
  v_mfma_f32_16x16x32_bf16 v[156:159], v[132:135], v[108:111], v[156:159]
  v_mfma_f32_16x16x32_bf16 v[160:163], v[120:123], v[104:107], v[160:163]
  v_mfma_f32_16x16x32_bf16 v[164:167], v[124:127], v[104:107], v[164:167]
  v_mfma_f32_16x16x32_bf16 v[160:163], v[136:139], v[108:111], v[160:163]
  v_mfma_f32_16x16x32_bf16 v[164:167], v[140:143], v[108:111], v[164:167]
  s_mov_b32 s93, 0
  s_mov_b32 s88, 0
  s_mov_b32 s19, 0xbfb8aa3b
  s_nop 1
  v_cvt_pk_bf16_f32 v92, v152, v153
  v_cvt_pk_bf16_f32 v93, v154, v155
  v_cvt_pk_bf16_f32 v94, v156, v157
  v_cvt_pk_bf16_f32 v95, v158, v159
  v_lshlrev_b32 v152, 16, v92
  v_and_b32 v153, s44, v92
  v_lshlrev_b32 v154, 16, v93
  v_and_b32 v155, s44, v93
  v_lshlrev_b32 v156, 16, v94
  v_and_b32 v157, s44, v94
  v_lshlrev_b32 v158, 16, v95
  v_and_b32 v159, s44, v95
  v_mov_b32 v100, s19
  v_mov_b32 v101, s19
  v_pk_mul_f32 v[152:153], v[152:153], v[100:101]
  v_pk_mul_f32 v[154:155], v[154:155], v[100:101]
  v_pk_mul_f32 v[156:157], v[156:157], v[100:101]
  v_pk_mul_f32 v[158:159], v[158:159], v[100:101]
  v_exp_f32 v152, v152
  v_exp_f32 v153, v153
  v_exp_f32 v154, v154
  v_exp_f32 v155, v155
  v_exp_f32 v156, v156
  v_exp_f32 v157, v157
  v_exp_f32 v158, v158
  v_exp_f32 v159, v159
  v_cvt_pk_bf16_f32 v96, v160, v161
  v_cvt_pk_bf16_f32 v97, v162, v163
  v_cvt_pk_bf16_f32 v98, v164, v165
  v_cvt_pk_bf16_f32 v99, v166, v167
  v_pk_add_f32 v[152:153], v[152:153], 1.0 op_sel_hi:[1,0]
  v_pk_add_f32 v[154:155], v[154:155], 1.0 op_sel_hi:[1,0]
  v_pk_add_f32 v[156:157], v[156:157], 1.0 op_sel_hi:[1,0]
  v_pk_add_f32 v[158:159], v[158:159], 1.0 op_sel_hi:[1,0]
  v_rcp_f32 v152, v152
  v_rcp_f32 v153, v153
  v_rcp_f32 v154, v154
  v_rcp_f32 v155, v155
  v_rcp_f32 v156, v156
  v_rcp_f32 v157, v157
  v_rcp_f32 v158, v158
  v_rcp_f32 v159, v159
  v_and_b32 v160, s89, v96
  v_and_b32 v161, s44, v96
  v_and_b32 v162, s89, v97
  v_and_b32 v163, s44, v97
  v_and_b32 v164, s89, v98
  v_and_b32 v165, s44, v98
  v_and_b32 v166, s89, v99
  v_and_b32 v167, s44, v99
  v_cvt_pk_bf16_f32 v92, v152, v153
  v_cvt_pk_bf16_f32 v93, v154, v155
  v_cvt_pk_bf16_f32 v94, v156, v157
  v_cvt_pk_bf16_f32 v95, v158, v159
  v_dot2_f32_bf16 v152, v92, v160, 0
  v_dot2_f32_bf16 v153, v92, v161, 0
  v_dot2_f32_bf16 v154, v93, v162, 0
  v_dot2_f32_bf16 v155, v93, v163, 0
  v_dot2_f32_bf16 v156, v94, v164, 0
  v_dot2_f32_bf16 v157, v94, v165, 0
  v_dot2_f32_bf16 v158, v95, v166, 0
  v_dot2_f32_bf16 v159, v95, v167, 0
  v_cvt_pk_bf16_f32 v168, v152, v153
  v_cvt_pk_bf16_f32 v169, v154, v155
  v_cvt_pk_bf16_f32 v170, v156, v157
  v_cvt_pk_bf16_f32 v171, v158, v159
  v_min_u32 v168, -2, v168
  v_min_u32 v169, -2, v169
  v_min_u32 v170, -2, v170
  v_min_u32 v171, -2, v171
  buffer_store_dwordx4 v[168:171], v72, s[32:35], s54 offen
L_S:
  s_barrier
  s_branch L_su
L_helper:
  s_cmp_eq_u32 s11, 7
  s_cbranch_scc0 L_hwait
  s_mul_i32 s52, s8, 896
  v_lshlrev_b32 v16, 11, v1
  s_mov_b32 s14, s10
  s_cmp_lt_u32 s14, 135
  s_cbranch_scc0 L_pfA_done
L_pfA:
  s_mul_i32 s19, s14, 4370
  s_lshr_b32 s19, s19, 16
  s_mul_i32 s47, s19, 15
  s_sub_u32 s47, s14, s47
  s_add_u32 s19, s19, 1
  s_cmp_eq_u32 s47, 14
  s_cbranch_scc1 L_pfA_x
  s_cmp_ge_u32 s47, 7
  s_cselect_b32 s49, 7, 0
  s_sub_u32 s48, s47, s49
  s_lshl_b32 s48, s48, 6
  v_add_u32 v14, s48, v1
  v_mul_u32_u24 v15, 9363, v14
  v_lshrrev_b32 v15, 16, v15
  v_mul_u32_u24 v15, 6272, v15
  v_lshl_add_u32 v14, v14, 7, v15
  s_mul_i32 s19, s19, 458752
  s_add_u32 s19, s19, s52
  s_waitcnt lgkmcnt(0)
  s_cmp_ge_u32 s47, 7
  s_cbranch_scc1 L_pfA_u
  buffer_load_dword v13, v14, s[24:27], s19 offen
  s_branch L_pfA_n
L_pfA_u:
  buffer_load_dword v13, v14, s[4:7], s19 offen
  s_branch L_pfA_n
L_pfA_x:
  s_waitcnt lgkmcnt(0)
  s_lshl_b32 s19, s19, 7
  buffer_load_dword v13, v16, s[20:23], s19 offen
L_pfA_n:
  s_add_u32 s14, s14, 14
  s_cmp_lt_u32 s14, 135
  s_cbranch_scc1 L_pfA
L_pfA_done:
  s_mov_b32 s14, s10
  s_cmp_lt_u32 s14, 90
  s_cbranch_scc0 L_pfB_done
L_pfB:
  s_mul_i32 s19, s14, 4370
  s_lshr_b32 s19, s19, 16
  s_mul_i32 s47, s19, 15
  s_sub_u32 s47, s14, s47
  s_add_u32 s19, s19, 10
  s_cmp_eq_u32 s47, 14
  s_cbranch_scc1 L_pfB_x
  s_cmp_ge_u32 s47, 7
  s_cselect_b32 s49, 7, 0
  s_sub_u32 s48, s47, s49
  s_lshl_b32 s48, s48, 6
  v_add_u32 v14, s48, v1
  v_mul_u32_u24 v15, 9363, v14
  v_lshrrev_b32 v15, 16, v15
  v_mul_u32_u24 v15, 6272, v15
  v_lshl_add_u32 v14, v14, 7, v15
  s_mul_i32 s19, s19, 458752
  s_add_u32 s19, s19, s52
  s_cmp_ge_u32 s47, 7
  s_cbranch_scc1 L_pfB_u
  buffer_load_dword v13, v14, s[24:27], s19 offen
  s_branch L_pfB_n
L_pfB_u:
  buffer_load_dword v13, v14, s[4:7], s19 offen
  s_branch L_pfB_n
L_pfB_x:
  s_lshl_b32 s19, s19, 7
  buffer_load_dword v13, v16, s[20:23], s19 offen
L_pfB_n:
  s_add_u32 s14, s14, 18
  s_cmp_lt_u32 s14, 90
  s_cbranch_scc1 L_pfB
L_pfB_done:
L_hwait:
  v_lshrrev_b32 v14, 3, v1
  v_and_b32 v15, 7, v1
  v_bfe_u32 v16, v1, 4, 2
  v_lshlrev_b32 v16, 1, v16
  v_xor_b32 v16, v15, v16
  v_lshlrev_b32 v16, 4, v16
  v_lshl_add_u32 v60, v14, 11, v16
  s_mul_i32 s55, s8, 917504
  s_lshl_b32 s19, s10, 7
  s_add_u32 s55, s55, s19
  s_movk_i32 s56, 1024
  s_movk_i32 s57, 16384
  s_lshl_b32 s19, s12, 10
  v_lshlrev_b32 v72, 4, v1
  v_add_u32 v61, s19, v72
  s_sub_i32 s19, s59, 1
  s_max_i32 s19, s19, 0
  s_lshl_b32 s3, s59, 2
  s_sub_u32 s3, s3, s19
  v_lshrrev_b32 v14, 2, v1
  v_lshlrev_b32 v14, 7, v14
  v_bfe_u32 v15, v1, 3, 2
  v_xor_b32 v15, s59, v15
  v_lshl_add_u32 v14, v15, 5, v14
  v_and_b32 v15, 3, v1
  v_lshl_add_u32 v14, v15, 3, v14
  s_lshl_b32 s19, s3, 12
  s_add_u32 s19, s19, 65536
  v_add_u32 v67, s19, v14
  v_xor_b32 v68, 32, v67
  v_xor_b32 v69, 64, v67
  v_xor_b32 v70, 96, v67
  v_lshrrev_b32 v14, 4, v1
  s_lshl_b32 s19, s12, 2
  v_add_u32 v14, s19, v14
  v_lshlrev_b32 v14, 13, v14
  v_and_b32 v15, 15, v1
  v_lshl_add_u32 v14, v15, 4, v14
  s_lshl_b32 s19, s59, 8
  v_add_u32 v62, s19, v14
  s_mul_i32 s19, s11, 3072
  s_add_u32 s19, s19, 0
  v_add_u32 v63, s19, v72
  s_xor_b32 s19, s11, 2
  s_mul_i32 s19, s19, 3072
  s_add_u32 s19, s19, 0
  v_add_u32 v64, s19, v72
  s_xor_b32 s19, s11, 4
  s_mul_i32 s19, s19, 3072
  s_add_u32 s19, s19, 1024
  v_add_u32 v65, s19, v72
  s_xor_b32 s19, s11, 6
  s_mul_i32 s19, s19, 3072
  s_add_u32 s19, s19, 2048
  v_add_u32 v66, s19, v72
  s_lshl_b32 s19, s8, 1
  s_add_u32 s19, s19, s9
  s_mul_i32 s45, s19, 28672
  s_lshl_b32 s19, s9, 4
  s_add_u32 s19, s19, s10
  s_lshl_b32 s19, s19, 16
  s_add_u32 s46, s19, 524288
  s_mov_b32 s44, 0xffff0000
  s_mov_b32 s89, 0xffff
  s_waitcnt lgkmcnt(0)
  s_barrier
  s_branch L_p2h
L_extra:
  s_lshl_b32 s19, s9, 1
  s_add_u32 s19, s19, s10
  s_sub_u32 s52, s19, 14
  v_lshlrev_b32 v72, 4, v1
  s_lshl_b32 s19, s8, 2
  s_add_u32 s53, s19, s52
  v_mov_b32 v92, -1
  v_mov_b32 v93, -1
  v_mov_b32 v94, -1
  v_mov_b32 v95, -1
  v_mov_b32 v17, 1
  s_lshl_b32 s48, s53, 14
  s_lshl_b32 s47, s11, 11
  s_add_u32 s48, s48, s47
  s_lshl_b32 s49, s53, 16
  s_lshl_b32 s47, s11, 13
  s_add_u32 s49, s49, s47
  s_add_u32 s49, s49, 524288
  s_waitcnt lgkmcnt(0)
  buffer_store_dwordx4 v[92:95], v72, s[32:35], s48 offen offset:0 sc1
  buffer_store_dwordx4 v[92:95], v72, s[32:35], s48 offen offset:1024 sc1
  s_barrier
  buffer_store_dwordx4 v[92:95], v72, s[32:35], s49 offen offset:0 sc1
  buffer_store_dwordx4 v[92:95], v72, s[32:35], s49 offen offset:1024 sc1
  buffer_store_dwordx4 v[92:95], v72, s[32:35], s49 offen offset:2048 sc1
  buffer_store_dwordx4 v[92:95], v72, s[32:35], s49 offen offset:3072 sc1
  s_add_u32 s49, s49, 4096
  buffer_store_dwordx4 v[92:95], v72, s[32:35], s49 offen offset:0 sc1
  buffer_store_dwordx4 v[92:95], v72, s[32:35], s49 offen offset:1024 sc1
  buffer_store_dwordx4 v[92:95], v72, s[32:35], s49 offen offset:2048 sc1
  buffer_store_dwordx4 v[92:95], v72, s[32:35], s49 offen offset:3072 sc1
  s_waitcnt vmcnt(8)
  s_barrier
  s_cmp_eq_u32 s11, 7
  s_cbranch_scc0 L_noatom
  s_mov_b64 exec, 1
  buffer_atomic_add v17, off, s[40:43], 0 sc1
  s_mov_b64 exec, -1
L_noatom:
  s_waitcnt vmcnt(0)
  s_barrier
  s_cmp_eq_u32 s11, 7
  s_cbranch_scc0 L_noatom2
  s_mov_b64 exec, 1
  buffer_atomic_add v17, off, s[40:43], 0 offset:128 sc1
  s_mov_b64 exec, -1
L_noatom2:
  s_cmp_eq_u32 s11, 6
  s_cbranch_scc0 L_xnopf
  s_add_u32 s14, s52, 14
  s_mul_i32 s52, s8, 896
  v_lshlrev_b32 v16, 11, v1
  s_cmp_lt_u32 s14, 90
  s_cbranch_scc0 L_pfC_done
L_pfC:
  s_mul_i32 s19, s14, 4370
  s_lshr_b32 s19, s19, 16
  s_mul_i32 s47, s19, 15
  s_sub_u32 s47, s14, s47
  s_add_u32 s19, s19, 10
  s_cmp_eq_u32 s47, 14
  s_cbranch_scc1 L_pfC_x
  s_cmp_ge_u32 s47, 7
  s_cselect_b32 s49, 7, 0
  s_sub_u32 s48, s47, s49
  s_lshl_b32 s48, s48, 6
  v_add_u32 v14, s48, v1
  v_mul_u32_u24 v15, 9363, v14
  v_lshrrev_b32 v15, 16, v15
  v_mul_u32_u24 v15, 6272, v15
  v_lshl_add_u32 v14, v14, 7, v15
  s_mul_i32 s19, s19, 458752
  s_add_u32 s19, s19, s52
  s_cmp_ge_u32 s47, 7
  s_cbranch_scc1 L_pfC_u
  buffer_load_dword v13, v14, s[24:27], s19 offen
  s_branch L_pfC_n
L_pfC_u:
  buffer_load_dword v13, v14, s[4:7], s19 offen
  s_branch L_pfC_n
L_pfC_x:
  s_lshl_b32 s19, s19, 7
  buffer_load_dword v13, v16, s[20:23], s19 offen
L_pfC_n:
  s_add_u32 s14, s14, 18
  s_cmp_lt_u32 s14, 90
  s_cbranch_scc1 L_pfC
L_pfC_done:
L_xnopf:
  s_barrier
  v_lshrrev_b32 v14, 3, v1
  v_and_b32 v15, 7, v1
  v_bfe_u32 v16, v1, 4, 2
  v_lshlrev_b32 v16, 1, v16
  v_xor_b32 v16, v15, v16
  v_lshlrev_b32 v16, 4, v16
  v_lshl_add_u32 v60, v14, 11, v16
  s_mul_i32 s55, s8, 917504
  s_lshl_b32 s19, s10, 7
  s_add_u32 s55, s55, s19
  s_movk_i32 s56, 1024
  s_movk_i32 s57, 16384
  s_lshl_b32 s19, s12, 10
  v_lshlrev_b32 v72, 4, v1
  v_add_u32 v61, s19, v72
  s_sub_i32 s19, s59, 1
  s_max_i32 s19, s19, 0
  s_lshl_b32 s3, s59, 2
  s_sub_u32 s3, s3, s19
  v_lshrrev_b32 v14, 2, v1
  v_lshlrev_b32 v14, 7, v14
  v_bfe_u32 v15, v1, 3, 2
  v_xor_b32 v15, s59, v15
  v_lshl_add_u32 v14, v15, 5, v14
  v_and_b32 v15, 3, v1
  v_lshl_add_u32 v14, v15, 3, v14
  s_lshl_b32 s19, s3, 12
  s_add_u32 s19, s19, 65536
  v_add_u32 v67, s19, v14
  v_xor_b32 v68, 32, v67
  v_xor_b32 v69, 64, v67
  v_xor_b32 v70, 96, v67
  v_lshrrev_b32 v14, 4, v1
  s_lshl_b32 s19, s12, 2
  v_add_u32 v14, s19, v14
  v_lshlrev_b32 v14, 13, v14
  v_and_b32 v15, 15, v1
  v_lshl_add_u32 v14, v15, 4, v14
  s_lshl_b32 s19, s59, 8
  v_add_u32 v62, s19, v14
  s_mul_i32 s19, s11, 3072
  s_add_u32 s19, s19, 0
  v_add_u32 v63, s19, v72
  s_xor_b32 s19, s11, 2
  s_mul_i32 s19, s19, 3072
  s_add_u32 s19, s19, 0
  v_add_u32 v64, s19, v72
  s_xor_b32 s19, s11, 4
  s_mul_i32 s19, s19, 3072
  s_add_u32 s19, s19, 1024
  v_add_u32 v65, s19, v72
  s_xor_b32 s19, s11, 6
  s_mul_i32 s19, s19, 3072
  s_add_u32 s19, s19, 2048
  v_add_u32 v66, s19, v72
  s_lshl_b32 s19, s8, 1
  s_add_u32 s19, s19, s9
  s_mul_i32 s45, s19, 28672
  s_lshl_b32 s19, s9, 4
  s_add_u32 s19, s19, s10
  s_lshl_b32 s19, s19, 16
  s_add_u32 s46, s19, 524288
  s_mov_b32 s44, 0xffff0000
  s_mov_b32 s89, 0xffff
L_p2h:
  s_mul_i32 s49, s11, 7
  s_lshl_b32 s19, s49, 10
  s_add_u32 m0, s19, 65536
  s_lshl_b32 s19, s49, 14
  s_add_u32 s48, s55, s19
  buffer_load_dwordx4 v60, s[28:31], s48 offen lds
  s_add_u32 m0, m0, s56
  s_add_u32 s48, s48, s57
  buffer_load_dwordx4 v60, s[28:31], s48 offen lds
  s_add_u32 m0, m0, s56
  s_add_u32 s48, s48, s57
  buffer_load_dwordx4 v60, s[28:31], s48 offen lds
  s_add_u32 m0, m0, s56
  s_add_u32 s48, s48, s57
  buffer_load_dwordx4 v60, s[28:31], s48 offen lds
  s_add_u32 m0, m0, s56
  s_add_u32 s48, s48, s57
  buffer_load_dwordx4 v60, s[28:31], s48 offen lds
  s_add_u32 m0, m0, s56
  s_add_u32 s48, s48, s57
  buffer_load_dwordx4 v60, s[28:31], s48 offen lds
  s_add_u32 m0, m0, s56
  s_add_u32 s48, s48, s57
  buffer_load_dwordx4 v60, s[28:31], s48 offen lds
  s_cmp_eq_u32 s11, 0
  s_cbranch_scc0 L_chk2ok
L_chk2:
  buffer_load_dword v13, off, s[40:43], 0 sc1
  s_waitcnt vmcnt(0)
  v_cmp_gt_u32 vcc, 32, v13
  s_nop 4
  s_cbranch_vccz L_chk2ok
  s_add_u32 s58, s58, 1
  s_cmp_gt_u32 s58, 0x8000
  s_cbranch_scc1 L_chk2ok
  s_sleep 16
  s_branch L_chk2
L_chk2ok:
  s_barrier
L_su:
  s_cmp_eq_u32 s11, 4
  s_cbranch_scc0 L_nochk3
  buffer_load_dword v13, off, s[40:43], 0 offset:128 sc1
L_nochk3:
  s_lshl_b32 s19, s3, 11
  s_add_u32 s47, s45, s19
  s_add_u32 s48, s47, 4096
  s_cmp_lt_u32 s59, 2
  s_cbranch_scc0 L_noA
  buffer_load_dwordx4 v[20:23], v61, s[32:35], s47 offen sc1
L_noA:
  buffer_load_dwordx4 v[24:27], v61, s[32:35], s47 offen offset:2048 sc1
  buffer_load_dwordx4 v[28:31], v61, s[32:35], s48 offen sc1
  buffer_load_dwordx4 v[32:35], v61, s[32:35], s48 offen offset:2048 sc1
  v_mov_b32 v76, 0
  v_mov_b32 v77, 0
  v_mov_b32 v78, 0
  v_mov_b32 v79, 0
  v_mov_b32 v80, 0
  v_mov_b32 v81, 0
  v_mov_b32 v82, 0
  v_mov_b32 v83, 0
  v_mov_b32 v84, 0
  v_mov_b32 v85, 0
  v_mov_b32 v86, 0
  v_mov_b32 v87, 0
  v_mov_b32 v88, 0
  v_mov_b32 v89, 0
  v_mov_b32 v90, 0
  v_mov_b32 v91, 0
  s_cmp_lt_u32 s59, 2
  s_cbranch_scc1 L_w4
  s_waitcnt vmcnt(3)
  s_branch L_wbar
L_w4:
  s_waitcnt vmcnt(4)
L_wbar:
  s_barrier
  s_cmp_lt_u32 s59, 2
  s_cbranch_scc0 L_skipA
  ds_read_b64_tr_b16 v[104:105], v67 offset:0
  ds_read_b64_tr_b16 v[106:107], v67 offset:2048
  ds_read_b64_tr_b16 v[108:109], v68 offset:0
  ds_read_b64_tr_b16 v[110:111], v68 offset:2048
  ds_read_b64_tr_b16 v[112:113], v69 offset:0
  ds_read_b64_tr_b16 v[114:115], v69 offset:2048
  ds_read_b64_tr_b16 v[116:117], v70 offset:0
  ds_read_b64_tr_b16 v[118:119], v70 offset:2048
  ds_read_b64_tr_b16 v[120:121], v67 offset:4096
  ds_read_b64_tr_b16 v[122:123], v67 offset:6144
  ds_read_b64_tr_b16 v[124:125], v68 offset:4096
  ds_read_b64_tr_b16 v[126:127], v68 offset:6144
  ds_read_b64_tr_b16 v[128:129], v69 offset:4096
  ds_read_b64_tr_b16 v[130:131], v69 offset:6144
  ds_read_b64_tr_b16 v[132:133], v70 offset:4096
  ds_read_b64_tr_b16 v[134:135], v70 offset:6144
  ds_read_b64_tr_b16 v[136:137], v67 offset:8192
  ds_read_b64_tr_b16 v[138:139], v67 offset:10240
  ds_read_b64_tr_b16 v[140:141], v68 offset:8192
  ds_read_b64_tr_b16 v[142:143], v68 offset:10240
  ds_read_b64_tr_b16 v[144:145], v69 offset:8192
  ds_read_b64_tr_b16 v[146:147], v69 offset:10240
  ds_read_b64_tr_b16 v[148:149], v70 offset:8192
  ds_read_b64_tr_b16 v[150:151], v70 offset:10240
  ds_read_b64_tr_b16 v[152:153], v67 offset:12288
  ds_read_b64_tr_b16 v[154:155], v67 offset:14336
  ds_read_b64_tr_b16 v[156:157], v68 offset:12288
  ds_read_b64_tr_b16 v[158:159], v68 offset:14336
  ds_read_b64_tr_b16 v[160:161], v69 offset:12288
  ds_read_b64_tr_b16 v[162:163], v69 offset:14336
  ds_read_b64_tr_b16 v[164:165], v70 offset:12288
  ds_read_b64_tr_b16 v[166:167], v70 offset:14336
  s_waitcnt vmcnt(3)
L_val0:
  v_max3_u32 v71, v20, v21, v22
  v_max_u32 v71, v71, v23
  v_cmp_eq_u32 vcc, -1, v71
  s_waitcnt lgkmcnt(14)
  s_nop 3
  s_cbranch_vccnz L_rel0
L_go0:
  v_mfma_f32_16x16x32_bf16 v[80:83], v[20:23], v[108:111], v[80:83]
  v_mfma_f32_16x16x32_bf16 v[84:87], v[20:23], v[112:115], v[84:87]
  v_mfma_f32_16x16x32_bf16 v[88:91], v[20:23], v[116:119], v[88:91]
  v_mfma_f32_16x16x32_bf16 v[76:79], v[20:23], v[104:107], v[76:79]
  s_branch L_stepB
L_skipA:
  ds_read_b64_tr_b16 v[120:121], v67 offset:4096
  ds_read_b64_tr_b16 v[122:123], v67 offset:6144
  ds_read_b64_tr_b16 v[124:125], v68 offset:4096
  ds_read_b64_tr_b16 v[126:127], v68 offset:6144
  ds_read_b64_tr_b16 v[128:129], v69 offset:4096
  ds_read_b64_tr_b16 v[130:131], v69 offset:6144
  ds_read_b64_tr_b16 v[132:133], v70 offset:4096
  ds_read_b64_tr_b16 v[134:135], v70 offset:6144
  ds_read_b64_tr_b16 v[136:137], v67 offset:8192
  ds_read_b64_tr_b16 v[138:139], v67 offset:10240
  ds_read_b64_tr_b16 v[140:141], v68 offset:8192
  ds_read_b64_tr_b16 v[142:143], v68 offset:10240
  ds_read_b64_tr_b16 v[144:145], v69 offset:8192
  ds_read_b64_tr_b16 v[146:147], v69 offset:10240
  ds_read_b64_tr_b16 v[148:149], v70 offset:8192
  ds_read_b64_tr_b16 v[150:151], v70 offset:10240
  ds_read_b64_tr_b16 v[152:153], v67 offset:12288
  ds_read_b64_tr_b16 v[154:155], v67 offset:14336
  ds_read_b64_tr_b16 v[156:157], v68 offset:12288
  ds_read_b64_tr_b16 v[158:159], v68 offset:14336
  ds_read_b64_tr_b16 v[160:161], v69 offset:12288
  ds_read_b64_tr_b16 v[162:163], v69 offset:14336
  ds_read_b64_tr_b16 v[164:165], v70 offset:12288
  ds_read_b64_tr_b16 v[166:167], v70 offset:14336
L_stepB:
  s_waitcnt vmcnt(2)
L_val1:
  v_max3_u32 v71, v24, v25, v26
  v_max_u32 v71, v71, v27
  v_cmp_eq_u32 vcc, -1, v71
  s_waitcnt lgkmcnt(14)
  s_nop 3
  s_cbranch_vccnz L_rel1
L_go1:
  v_mfma_f32_16x16x32_bf16 v[80:83], v[24:27], v[124:127], v[80:83]
  v_mfma_f32_16x16x32_bf16 v[84:87], v[24:27], v[128:131], v[84:87]
  v_mfma_f32_16x16x32_bf16 v[88:91], v[24:27], v[132:135], v[88:91]
  v_mfma_f32_16x16x32_bf16 v[76:79], v[24:27], v[120:123], v[76:79]
  s_waitcnt vmcnt(1)
L_val2:
  v_max3_u32 v71, v28, v29, v30
  v_max_u32 v71, v71, v31
  v_cmp_eq_u32 vcc, -1, v71
  s_waitcnt lgkmcnt(8)
  s_nop 3
  s_cbranch_vccnz L_rel2
L_go2:
  v_mfma_f32_16x16x32_bf16 v[80:83], v[28:31], v[140:143], v[80:83]
  v_mfma_f32_16x16x32_bf16 v[84:87], v[28:31], v[144:147], v[84:87]
  v_mfma_f32_16x16x32_bf16 v[88:91], v[28:31], v[148:151], v[88:91]
  v_mfma_f32_16x16x32_bf16 v[76:79], v[28:31], v[136:139], v[76:79]
  s_waitcnt vmcnt(0)
L_val3:
  v_max3_u32 v71, v32, v33, v34
  v_max_u32 v71, v71, v35
  v_cmp_eq_u32 vcc, -1, v71
  s_waitcnt lgkmcnt(0)
  s_nop 3
  s_cbranch_vccnz L_rel3
L_go3:
  v_mfma_f32_16x16x32_bf16 v[80:83], v[32:35], v[156:159], v[80:83]
  v_mfma_f32_16x16x32_bf16 v[84:87], v[32:35], v[160:163], v[84:87]
  v_mfma_f32_16x16x32_bf16 v[88:91], v[32:35], v[164:167], v[88:91]
  v_mfma_f32_16x16x32_bf16 v[76:79], v[32:35], v[152:155], v[76:79]
  s_nop 3
  s_branch L_p2ok
L_rel0:
  s_add_u32 s58, s58, 1
  s_cmp_gt_u32 s58, 0x8000
  s_cbranch_scc1 L_go0
  s_cmp_eq_u32 s88, 1
  s_cbranch_scc0 L_pub1
  v_mov_b32 v100, 1
  v_mov_b32 v101, 1
  v_mov_b32 v102, 1
  v_mov_b32 v103, 1
  s_waitcnt vmcnt(0)
  s_mov_b64 exec, 0xff
  buffer_store_dwordx4 v[100:103], v72, s[32:35], s87 offen sc1
  s_mov_b64 exec, -1
  s_mov_b32 s88, 2
L_pub1:
  s_add_u32 s90, s90, 1
  s_cmp_lt_u32 s90, 3
  s_cbranch_scc1 L_nopub0
  s_cmp_eq_u32 s93, 0
  s_cbranch_scc0 L_pub2
  s_add_u32 s49, s54, 2621440
  buffer_store_dwordx4 v[168:171], v72, s[32:35], s49 offen sc1
  s_mov_b32 s93, 1
  s_mov_b32 s88, 1
L_pub2:
  s_cmp_lt_u32 s90, 6
  s_cbranch_scc1 L_nopub0
  s_bitcmp1_b32 s90, 0
  s_cbranch_scc1 L_nopub0
  s_add_u32 s19, s3, 0
  s_mul_i32 s49, s8, 14
  s_add_u32 s19, s19, s49
  s_lshl_b32 s19, s19, 2
  s_lshl_b32 s48, s9, 1
  s_add_u32 s19, s19, s48
  s_add_u32 s19, s19, s12
  s_lshl_b32 s19, s19, 7
  s_add_u32 s19, s19, 458752
  buffer_load_dword v14, off, s[32:35], s19 sc1
  s_waitcnt vmcnt(0)
  v_cmp_eq_u32 vcc, -1, v14
  s_nop 4
  s_cbranch_vccnz L_nopub0
  s_add_u32 s48, s47, 2621440
  buffer_load_dwordx4 v[20:23], v61, s[32:35], s48 offen sc1
  s_waitcnt vmcnt(0)
  s_branch L_val0
L_nopub0:
  s_sleep 2
  s_add_u32 s48, s47, 0
  buffer_load_dwordx4 v[20:23], v61, s[32:35], s48 offen sc1
  s_add_u32 s48, s47, 2048
  buffer_load_dwordx4 v[24:27], v61, s[32:35], s48 offen sc1
  s_add_u32 s48, s47, 4096
  buffer_load_dwordx4 v[28:31], v61, s[32:35], s48 offen sc1
  s_add_u32 s48, s47, 6144
  buffer_load_dwordx4 v[32:35], v61, s[32:35], s48 offen sc1
  s_waitcnt vmcnt(3)
  s_branch L_val0
L_rel1:
  s_add_u32 s58, s58, 1
  s_cmp_gt_u32 s58, 0x8000
  s_cbranch_scc1 L_go1
  s_cmp_eq_u32 s88, 1
  s_cbranch_scc0 L_pub3
  v_mov_b32 v100, 1
  v_mov_b32 v101, 1
  v_mov_b32 v102, 1
  v_mov_b32 v103, 1
  s_waitcnt vmcnt(0)
  s_mov_b64 exec, 0xff
  buffer_store_dwordx4 v[100:103], v72, s[32:35], s87 offen sc1
  s_mov_b64 exec, -1
  s_mov_b32 s88, 2
L_pub3:
  s_add_u32 s90, s90, 1
  s_cmp_lt_u32 s90, 3
  s_cbranch_scc1 L_nopub1
  s_cmp_eq_u32 s93, 0
  s_cbranch_scc0 L_pub4
  s_add_u32 s49, s54, 2621440
  buffer_store_dwordx4 v[168:171], v72, s[32:35], s49 offen sc1
  s_mov_b32 s93, 1
  s_mov_b32 s88, 1
L_pub4:
  s_cmp_lt_u32 s90, 6
  s_cbranch_scc1 L_nopub1
  s_bitcmp1_b32 s90, 0
  s_cbranch_scc1 L_nopub1
  s_add_u32 s19, s3, 1
  s_mul_i32 s49, s8, 14
  s_add_u32 s19, s19, s49
  s_lshl_b32 s19, s19, 2
  s_lshl_b32 s48, s9, 1
  s_add_u32 s19, s19, s48
  s_add_u32 s19, s19, s12
  s_lshl_b32 s19, s19, 7
  s_add_u32 s19, s19, 458752
  buffer_load_dword v14, off, s[32:35], s19 sc1
  s_waitcnt vmcnt(0)
  v_cmp_eq_u32 vcc, -1, v14
  s_nop 4
  s_cbranch_vccnz L_nopub1
  s_add_u32 s48, s47, 2623488
  buffer_load_dwordx4 v[24:27], v61, s[32:35], s48 offen sc1
  s_waitcnt vmcnt(0)
  s_branch L_val1
L_nopub1:
  s_sleep 2
  s_add_u32 s48, s47, 2048
  buffer_load_dwordx4 v[24:27], v61, s[32:35], s48 offen sc1
  s_add_u32 s48, s47, 4096
  buffer_load_dwordx4 v[28:31], v61, s[32:35], s48 offen sc1
  s_add_u32 s48, s47, 6144
  buffer_load_dwordx4 v[32:35], v61, s[32:35], s48 offen sc1
  s_waitcnt vmcnt(2)
  s_branch L_val1
L_rel2:
  s_add_u32 s58, s58, 1
  s_cmp_gt_u32 s58, 0x8000
  s_cbranch_scc1 L_go2
  s_cmp_eq_u32 s88, 1
  s_cbranch_scc0 L_pub5
  v_mov_b32 v100, 1
  v_mov_b32 v101, 1
  v_mov_b32 v102, 1
  v_mov_b32 v103, 1
  s_waitcnt vmcnt(0)
  s_mov_b64 exec, 0xff
  buffer_store_dwordx4 v[100:103], v72, s[32:35], s87 offen sc1
  s_mov_b64 exec, -1
  s_mov_b32 s88, 2
L_pub5:
  s_add_u32 s90, s90, 1
  s_cmp_lt_u32 s90, 3
  s_cbranch_scc1 L_nopub2
  s_cmp_eq_u32 s93, 0
  s_cbranch_scc0 L_pub6
  s_add_u32 s49, s54, 2621440
  buffer_store_dwordx4 v[168:171], v72, s[32:35], s49 offen sc1
  s_mov_b32 s93, 1
  s_mov_b32 s88, 1
L_pub6:
  s_cmp_lt_u32 s90, 6
  s_cbranch_scc1 L_nopub2
  s_bitcmp1_b32 s90, 0
  s_cbranch_scc1 L_nopub2
  s_add_u32 s19, s3, 2
  s_mul_i32 s49, s8, 14
  s_add_u32 s19, s19, s49
  s_lshl_b32 s19, s19, 2
  s_lshl_b32 s48, s9, 1
  s_add_u32 s19, s19, s48
  s_add_u32 s19, s19, s12
  s_lshl_b32 s19, s19, 7
  s_add_u32 s19, s19, 458752
  buffer_load_dword v14, off, s[32:35], s19 sc1
  s_waitcnt vmcnt(0)
  v_cmp_eq_u32 vcc, -1, v14
  s_nop 4
  s_cbranch_vccnz L_nopub2
  s_add_u32 s48, s47, 2625536
  buffer_load_dwordx4 v[28:31], v61, s[32:35], s48 offen sc1
  s_waitcnt vmcnt(0)
  s_branch L_val2
L_nopub2:
  s_sleep 2
  s_add_u32 s48, s47, 4096
  buffer_load_dwordx4 v[28:31], v61, s[32:35], s48 offen sc1
  s_add_u32 s48, s47, 6144
  buffer_load_dwordx4 v[32:35], v61, s[32:35], s48 offen sc1
  s_waitcnt vmcnt(1)
  s_branch L_val2
L_rel3:
  s_add_u32 s58, s58, 1
  s_cmp_gt_u32 s58, 0x8000
  s_cbranch_scc1 L_go3
  s_cmp_eq_u32 s88, 1
  s_cbranch_scc0 L_pub7
  v_mov_b32 v100, 1
  v_mov_b32 v101, 1
  v_mov_b32 v102, 1
  v_mov_b32 v103, 1
  s_waitcnt vmcnt(0)
  s_mov_b64 exec, 0xff
  buffer_store_dwordx4 v[100:103], v72, s[32:35], s87 offen sc1
  s_mov_b64 exec, -1
  s_mov_b32 s88, 2
L_pub7:
  s_add_u32 s90, s90, 1
  s_cmp_lt_u32 s90, 3
  s_cbranch_scc1 L_nopub3
  s_cmp_eq_u32 s93, 0
  s_cbranch_scc0 L_pub8
  s_add_u32 s49, s54, 2621440
  buffer_store_dwordx4 v[168:171], v72, s[32:35], s49 offen sc1
  s_mov_b32 s93, 1
  s_mov_b32 s88, 1
L_pub8:
  s_cmp_lt_u32 s90, 6
  s_cbranch_scc1 L_nopub3
  s_bitcmp1_b32 s90, 0
  s_cbranch_scc1 L_nopub3
  s_add_u32 s19, s3, 3
  s_mul_i32 s49, s8, 14
  s_add_u32 s19, s19, s49
  s_lshl_b32 s19, s19, 2
  s_lshl_b32 s48, s9, 1
  s_add_u32 s19, s19, s48
  s_add_u32 s19, s19, s12
  s_lshl_b32 s19, s19, 7
  s_add_u32 s19, s19, 458752
  buffer_load_dword v14, off, s[32:35], s19 sc1
  s_waitcnt vmcnt(0)
  v_cmp_eq_u32 vcc, -1, v14
  s_nop 4
  s_cbranch_vccnz L_nopub3
  s_add_u32 s48, s47, 2627584
  buffer_load_dwordx4 v[32:35], v61, s[32:35], s48 offen sc1
  s_waitcnt vmcnt(0)
  s_branch L_val3
L_nopub3:
  s_sleep 2
  s_add_u32 s48, s47, 6144
  buffer_load_dwordx4 v[32:35], v61, s[32:35], s48 offen sc1
  s_waitcnt vmcnt(0)
  s_branch L_val3
L_p2ok:
  s_nop 3
  ds_write_b128 v63, v[80:83] offset:0
  ds_write_b128 v63, v[84:87] offset:1024
  ds_write_b128 v63, v[88:91] offset:2048
  s_cmp_eq_u32 s93, 0
  s_cbranch_scc0 L_pub9
  s_add_u32 s49, s54, 2621440
  buffer_store_dwordx4 v[168:171], v72, s[32:35], s49 offen sc1
  s_mov_b32 s93, 1
  s_mov_b32 s88, 1
L_pub9:
  s_cmp_eq_u32 s11, 4
  s_cbranch_scc0 L_chk3ok
L_chk3:
  v_cmp_gt_u32 vcc, 32, v13
  s_nop 4
  s_cbranch_vccz L_chk3ok
  s_add_u32 s58, s58, 1
  s_cmp_gt_u32 s58, 0x8000
  s_cbranch_scc1 L_chk3ok
  s_sleep 8
  buffer_load_dword v13, off, s[40:43], 0 offset:128 sc1
  s_waitcnt vmcnt(0)
  s_branch L_chk3
L_chk3ok:
  s_waitcnt lgkmcnt(0)
  s_barrier
  ds_read_b128 v[92:95], v64
  ds_read_b128 v[96:99], v65
  ds_read_b128 v[100:103], v66
  s_lshl_b32 s19, s8, 10
  s_add_u32 s19, s19, s46
  s_waitcnt lgkmcnt(2)
  v_pk_add_f32 v[76:77], v[76:77], v[92:93]
  v_pk_add_f32 v[78:79], v[78:79], v[94:95]
  s_waitcnt lgkmcnt(1)
  v_pk_add_f32 v[76:77], v[76:77], v[96:97]
  v_pk_add_f32 v[78:79], v[78:79], v[98:99]
  s_waitcnt lgkmcnt(0)
  v_pk_add_f32 v[76:77], v[76:77], v[100:101]
  v_pk_add_f32 v[78:79], v[78:79], v[102:103]
  v_min_u32 v76, -2, v76
  v_min_u32 v77, -2, v77
  v_min_u32 v78, -2, v78
  v_min_u32 v79, -2, v79
  buffer_store_dwordx4 v[76:79], v62, s[32:35], s19 offen sc1
  s_cmp_eq_u32 s88, 1
  s_cbranch_scc0 L_pub10
  v_mov_b32 v100, 1
  v_mov_b32 v101, 1
  v_mov_b32 v102, 1
  v_mov_b32 v103, 1
  s_waitcnt vmcnt(1)
  s_mov_b64 exec, 0xff
  buffer_store_dwordx4 v[100:103], v72, s[32:35], s87 offen sc1
  s_mov_b64 exec, -1
  s_mov_b32 s88, 2
L_pub10:
  s_cmp_eq_u32 s11, 4
  s_cbranch_scc0 L_fin
  s_lshl_b32 s19, s8, 13
  s_add_u32 s19, s19, s46
  s_add_u32 s47, s19, 4096
  s_lshl_b32 s48, s9, 5
  s_lshl_b32 s49, s8, 2
  s_add_u32 s48, s48, s49
  s_lshl_b32 s48, s48, 11
  s_lshl_b32 s49, s10, 7
  s_add_u32 s48, s48, s49
  s_add_u32 s49, s48, 4096
  v_lshlrev_b32 v14, 1, v1
  buffer_load_dwordx4 v[20:23], v72, s[32:35], s19 offen offset:0 sc1
  buffer_load_dwordx4 v[24:27], v72, s[32:35], s19 offen offset:1024 sc1
  buffer_load_dwordx4 v[28:31], v72, s[32:35], s19 offen offset:2048 sc1
  buffer_load_dwordx4 v[32:35], v72, s[32:35], s19 offen offset:3072 sc1
  buffer_load_dwordx4 v[36:39], v72, s[32:35], s47 offen offset:0 sc1
  buffer_load_dwordx4 v[40:43], v72, s[32:35], s47 offen offset:1024 sc1
  buffer_load_dwordx4 v[44:47], v72, s[32:35], s47 offen offset:2048 sc1
  buffer_load_dwordx4 v[48:51], v72, s[32:35], s47 offen offset:3072 sc1
L_gather:
  buffer_load_dwordx4 v[104:107], v72, s[32:35], s19 offen offset:0 sc1
  buffer_load_dwordx4 v[108:111], v72, s[32:35], s19 offen offset:1024 sc1
  buffer_load_dwordx4 v[112:115], v72, s[32:35], s19 offen offset:2048 sc1
  buffer_load_dwordx4 v[116:119], v72, s[32:35], s19 offen offset:3072 sc1
  buffer_load_dwordx4 v[120:123], v72, s[32:35], s47 offen offset:0 sc1
  buffer_load_dwordx4 v[124:127], v72, s[32:35], s47 offen offset:1024 sc1
  buffer_load_dwordx4 v[128:131], v72, s[32:35], s47 offen offset:2048 sc1
  buffer_load_dwordx4 v[132:135], v72, s[32:35], s47 offen offset:3072 sc1
  s_waitcnt vmcnt(8)
  v_pk_add_f32 v[76:77], v[20:21], v[24:25]
  v_pk_add_f32 v[78:79], v[22:23], v[26:27]
  v_pk_add_f32 v[80:81], v[28:29], v[32:33]
  v_pk_add_f32 v[82:83], v[30:31], v[34:35]
  v_pk_add_f32 v[84:85], v[36:37], v[40:41]
  v_pk_add_f32 v[86:87], v[38:39], v[42:43]
  v_pk_add_f32 v[88:89], v[44:45], v[48:49]
  v_pk_add_f32 v[90:91], v[46:47], v[50:51]
  v_pk_add_f32 v[76:77], v[76:77], v[80:81]
  v_pk_add_f32 v[84:85], v[84:85], v[88:89]
  v_pk_add_f32 v[78:79], v[78:79], v[82:83]
  v_pk_add_f32 v[86:87], v[86:87], v[90:91]
  v_pk_add_f32 v[96:97], v[76:77], v[84:85]
  v_pk_add_f32 v[98:99], v[78:79], v[86:87]
  v_add_f32 v100, v96, v97
  v_add_f32 v101, v98, v99
  v_cmp_u_f32 vcc, v100, v101
  s_nop 4
  s_cbranch_vccz L_gout
  v_max3_u32 v71, v20, v21, v22
  v_max3_u32 v71, v71, v23, v24
  v_max3_u32 v71, v71, v25, v26
  v_max3_u32 v71, v71, v27, v28
  v_max3_u32 v71, v71, v29, v30
  v_max3_u32 v71, v71, v31, v32
  v_max3_u32 v71, v71, v33, v34
  v_max3_u32 v71, v71, v35, v36
  v_max3_u32 v71, v71, v37, v38
  v_max3_u32 v71, v71, v39, v40
  v_max3_u32 v71, v71, v41, v42
  v_max3_u32 v71, v71, v43, v44
  v_max3_u32 v71, v71, v45, v46
  v_max3_u32 v71, v71, v47, v48
  v_max3_u32 v71, v71, v49, v50
  v_max_u32 v71, v71, v51
  v_cmp_eq_u32 vcc, -1, v71
  s_nop 4
  s_cbranch_vccz L_gout
  s_add_u32 s58, s58, 1
  s_cmp_gt_u32 s58, 0x8000
  s_cbranch_scc1 L_gout
  buffer_load_dwordx4 v[20:23], v72, s[32:35], s19 offen offset:0 sc1
  buffer_load_dwordx4 v[24:27], v72, s[32:35], s19 offen offset:1024 sc1
  buffer_load_dwordx4 v[28:31], v72, s[32:35], s19 offen offset:2048 sc1
  buffer_load_dwordx4 v[32:35], v72, s[32:35], s19 offen offset:3072 sc1
  buffer_load_dwordx4 v[36:39], v72, s[32:35], s47 offen offset:0 sc1
  buffer_load_dwordx4 v[40:43], v72, s[32:35], s47 offen offset:1024 sc1
  buffer_load_dwordx4 v[44:47], v72, s[32:35], s47 offen offset:2048 sc1
  buffer_load_dwordx4 v[48:51], v72, s[32:35], s47 offen offset:3072 sc1
  s_waitcnt vmcnt(8)
  v_pk_add_f32 v[76:77], v[104:105], v[108:109]
  v_pk_add_f32 v[78:79], v[106:107], v[110:111]
  v_pk_add_f32 v[80:81], v[112:113], v[116:117]
  v_pk_add_f32 v[82:83], v[114:115], v[118:119]
  v_pk_add_f32 v[84:85], v[120:121], v[124:125]
  v_pk_add_f32 v[86:87], v[122:123], v[126:127]
  v_pk_add_f32 v[88:89], v[128:129], v[132:133]
  v_pk_add_f32 v[90:91], v[130:131], v[134:135]
  v_pk_add_f32 v[76:77], v[76:77], v[80:81]
  v_pk_add_f32 v[84:85], v[84:85], v[88:89]
  v_pk_add_f32 v[78:79], v[78:79], v[82:83]
  v_pk_add_f32 v[86:87], v[86:87], v[90:91]
  v_pk_add_f32 v[96:97], v[76:77], v[84:85]
  v_pk_add_f32 v[98:99], v[78:79], v[86:87]
  v_add_f32 v100, v96, v97
  v_add_f32 v101, v98, v99
  v_cmp_u_f32 vcc, v100, v101
  s_nop 4
  s_cbranch_vccz L_gout
  v_max3_u32 v71, v104, v105, v106
  v_max3_u32 v71, v71, v107, v108
  v_max3_u32 v71, v71, v109, v110
  v_max3_u32 v71, v71, v111, v112
  v_max3_u32 v71, v71, v113, v114
  v_max3_u32 v71, v71, v115, v116
  v_max3_u32 v71, v71, v117, v118
  v_max3_u32 v71, v71, v119, v120
  v_max3_u32 v71, v71, v121, v122
  v_max3_u32 v71, v71, v123, v124
  v_max3_u32 v71, v71, v125, v126
  v_max3_u32 v71, v71, v127, v128
  v_max3_u32 v71, v71, v129, v130
  v_max3_u32 v71, v71, v131, v132
  v_max3_u32 v71, v71, v133, v134
  v_max_u32 v71, v71, v135
  v_cmp_eq_u32 vcc, -1, v71
  s_nop 4
  s_cbranch_vccz L_gout
  s_add_u32 s58, s58, 1
  s_cmp_gt_u32 s58, 0x8000
  s_cbranch_scc1 L_gout
  s_branch L_gather
L_gout:
  v_cvt_pk_bf16_f32 v92, v96, v97
  v_cvt_pk_bf16_f32 v93, v98, v99
  buffer_store_short v92, v14, s[36:39], s48 offen
  buffer_store_short_d16_hi v92, v14, s[36:39], s48 offen offset:2048
  buffer_store_short v93, v14, s[36:39], s49 offen
  buffer_store_short_d16_hi v93, v14, s[36:39], s49 offen offset:2048
L_fin:
L_end:
  s_endpgm
L_codeend:
.section .rodata,"a"
.p2align 6
.amdhsa_kernel standalone__glu_gated_glu__sampling_kernel
  .amdhsa_next_free_vgpr 172
  .amdhsa_next_free_sgpr 102
  .amdhsa_accum_offset 172
  .amdhsa_group_segment_fixed_size 0
  .amdhsa_kernarg_size 56
  .amdhsa_user_sgpr_count 2
  .amdhsa_user_sgpr_kernarg_segment_ptr 1
  .amdhsa_system_sgpr_workgroup_id_x 1
  .amdhsa_float_denorm_mode_32 3
.end_amdhsa_kernel
```
